```python
import torch

def _softmax(x, axis=-1):
    return torch.softmax(x, dim=axis)

def _gelu(x):
    return torch.nn.functional.gelu(x, approximate='tanh')

def _silu(x):
    return torch.nn.functional.silu(x)

def _sigmoid(x):
    return torch.sigmoid(x)

def _layernorm(x, axis=-1, eps=1e-05):
    m = x.mean(dim=axis, keepdim=True)
    v = x.var(dim=axis, keepdim=True, unbiased=False)
    return (x - m) / torch.sqrt(v + eps)

def _scatter_add(tgt, idx, src, axis=0):
    return tgt.clone().index_add_(axis, idx, src)

def _segment_sum(src, seg, n):
    out = torch.zeros((n,) + src.shape[1:], dtype=src.dtype)
    return out.index_add_(0, seg, src)

def _pad(x, pw):
    flat = tuple((v for pair in reversed(pw) for v in pair))
    return torch.nn.functional.pad(x, flat)
kernel_name = 'gather_scatter__tensor_product_equiv_mace__graph'

def setup_inputs():

    _w = lambda a: (lambda t: t.to(torch.bfloat16) if t.is_floating_point() else t)(torch.as_tensor(a))
    N, deg = (10000, 32)
    Lmax, C, De = (1, 128, 4)
    M = (Lmax + 1) ** 2
    E = N * deg
    src = (lambda lo, hi, *s: torch.randint(lo, hi, s))(0, N, E).to(torch.int64)
    dst = (lambda lo, hi, *s: torch.randint(lo, hi, s))(0, N, E).to(torch.int64)
    r = (lambda *s: torch.randn(*s, dtype=torch.bfloat16) * 0.05)(E, 3).to(float)
    r = r / (torch.linalg.norm(r, dim=-1, keepdim=True).to(float) + 1e-06)
    rx, ry, rz = (r[:, 0].clone(), r[:, 1].clone(), r[:, 2].clone())
    x2, y2, z2 = (rx * rx, ry * ry, rz * rz)
    sh_list = [torch.ones_like(rx), rx, ry, rz, rx * ry, ry * rz, 2.0 * z2 - x2 - y2, rx * rz, x2 - y2, ry * (3.0 * x2 - y2), rx * ry * rz, ry * (4.0 * z2 - x2 - y2), rz * (2.0 * z2 - 3.0 * x2 - 3.0 * y2), rx * (4.0 * z2 - x2 - y2), rz * (x2 - y2), rx * (x2 - 3.0 * y2)]
    sh16 = torch.stack(sh_list, dim=-1).to(float)
    pad = max(0, M - 16)
    sh_full = torch.cat([sh16, torch.zeros((E, pad), dtype=float)], dim=-1)[:, :M]
    cg = ((lambda *s: torch.randn(*s, dtype=torch.bfloat16) * 0.05)(M, M, M) * (1.0 / float(M))).to(float)
    return {'x': _w(((lambda *s: torch.randn(*s, dtype=torch.bfloat16) * 0.05)(N, M, C) * 0.3).to(float)), 'src': _w(src), 'dst': _w(dst), 'sh': _w(sh_full.to(float)), 'edge_attr': _w(((lambda *s: torch.randn(*s, dtype=torch.bfloat16) * 0.05)(E, De) * 0.3).to(float)), 'cg': _w(cg), 'w_r': _w(((lambda *s: torch.randn(*s, dtype=torch.bfloat16) * 0.05)(De, C) * (1.0 / float(De) ** 0.5)).to(float)), 'w_out': _w(((lambda *s: torch.randn(*s, dtype=torch.bfloat16) * 0.05)(C, C) * (1.0 / float(C) ** 0.5)).to(float))}

def reference(x, src, dst, sh, edge_attr, cg, w_r, w_out):
    N = x.shape[0]
    M = x.shape[1]
    C = x.shape[2]
    h = x[src]
    tp = torch.einsum('uvw,euc,ev->ewc', cg, h, sh)
    rw = edge_attr @ w_r
    msg = tp * rw[:, None, :]
    msg2 = msg.reshape(-1, M * C)
    agg = _segment_sum(msg2, dst, N).reshape(N, M, C)
    out = torch.einsum('nmc,cd->nmd', agg, w_out)
    return out
```

```asm
; @launch kernel=gs_bin_kernel grid=(256,1,1) block=(640,1,1) lds=27648
; @launch kernel=gather_scatter__tensor_product_equiv_mace__graph_kernel grid=(256,1,1) block=(1024,1,1) lds=161792
.amdgcn_target "amdgcn-amd-amdhsa--gfx950"
.text
.globl gs_bin_kernel
.p2align 8
.type gs_bin_kernel,@function
gs_bin_kernel:
    s_cmp_ge_u32 s2, 256
    s_cbranch_scc1 K1_done
    s_load_dwordx16 s[4:19], s[0:1], 0
    s_load_dwordx2 s[22:23], s[0:1], 80
    s_cmp_ge_u32 s2, 250
    s_cbranch_scc1 K1_wimg
    s_mul_i32 s3, s2, 1280
    v_lshl_add_u32 v1, v0, 1, s3
    v_lshlrev_b32 v2, 2, v1
    v_lshlrev_b32 v3, 3, v1
    v_lshlrev_b32 v20, 2, v0
    v_mov_b32 v21, 0
    v_mov_b32 v22, 1
    s_waitcnt lgkmcnt(0)
    global_load_dwordx2 v[4:5], v2, s[8:9]
    global_load_dwordx2 v[6:7], v2, s[6:7]
    global_load_dwordx4 v[8:11], v3, s[10:11]
    global_load_dwordx4 v[12:15], v3, s[12:13]
    v_cmp_gt_u32 vcc, 256, v0
    s_and_saveexec_b64 s[24:25], vcc
    ds_write_b32 v20, v21 offset:0
    s_mov_b64 exec, s[24:25]
    s_waitcnt lgkmcnt(0)
    s_barrier
    s_waitcnt vmcnt(3)
    v_and_b32 v16, 7, v4
    v_bfe_u32 v42, v4, 3, 5
    v_lshlrev_b32 v42, 2, v42
    v_lshl_or_b32 v16, v16, 7, v42
    v_and_b32 v17, 7, v5
    v_bfe_u32 v43, v5, 3, 5
    v_lshlrev_b32 v43, 2, v43
    v_lshl_or_b32 v17, v17, 7, v43
    ds_add_rtn_u32 v18, v16, v22 offset:0
    ds_add_rtn_u32 v19, v17, v22 offset:0
    v_lshrrev_b32 v4, 8, v4
    v_lshrrev_b32 v5, 8, v5
    s_waitcnt lgkmcnt(0)
    s_barrier
    v_cmp_gt_u32 vcc, 64, v0
    s_and_saveexec_b64 s[24:25], vcc
    s_cbranch_execz K1_scan_done
    v_lshlrev_b32 v23, 4, v0
    ds_read_b128 v[24:27], v23 offset:0
    s_waitcnt lgkmcnt(0)
    v_add_u32 v28, v24, v25
    v_add_u32 v29, v28, v26
    v_add_u32 v30, v29, v27
    v_mov_b32 v31, v30
    s_nop 1
    v_add_u32_dpp v31, v31, v31 row_shr:1 row_mask:0xf bank_mask:0xf bound_ctrl:0
    s_nop 1
    v_add_u32_dpp v31, v31, v31 row_shr:2 row_mask:0xf bank_mask:0xf bound_ctrl:0
    s_nop 1
    v_add_u32_dpp v31, v31, v31 row_shr:4 row_mask:0xf bank_mask:0xf bound_ctrl:0
    s_nop 1
    v_add_u32_dpp v31, v31, v31 row_shr:8 row_mask:0xf bank_mask:0xf bound_ctrl:0
    s_nop 1
    v_add_u32_dpp v31, v31, v31 row_bcast:15 row_mask:0xa bank_mask:0xf
    s_nop 1
    v_add_u32_dpp v31, v31, v31 row_bcast:31 row_mask:0xc bank_mask:0xf
    s_nop 1
    v_sub_u32 v32, v31, v30
    v_add_u32 v33, v32, v24
    v_add_u32 v34, v32, v28
    v_add_u32 v35, v32, v29
    ds_write_b128 v23, v[32:35] offset:1024
    v_lshl_or_b32 v36, v24, 16, v32
    v_lshl_or_b32 v37, v25, 16, v33
    v_lshl_or_b32 v38, v26, 16, v34
    v_lshl_or_b32 v39, v27, 16, v35
    s_and_b32 s3, s2, 7
    s_lshl_b32 s3, s3, 5
    s_lshr_b32 s26, s2, 3
    s_add_u32 s3, s3, s26
    s_lshl_b32 s3, s3, 2
    s_add_u32 s3, s3, 0x700000
    v_lshl_add_u32 v44, v23, 8, s3
    global_store_dword v44, v36, s[22:23] offset:0
    global_store_dword v44, v37, s[22:23] offset:1024
    global_store_dword v44, v38, s[22:23] offset:2048
    global_store_dword v44, v39, s[22:23] offset:3072
    s_waitcnt lgkmcnt(0)
K1_scan_done:
    s_mov_b64 exec, s[24:25]
    s_barrier
    ds_read_b32 v24, v16 offset:1024
    ds_read_b32 v25, v17 offset:1024
    s_waitcnt vmcnt(0)
    v_lshl_or_b32 v4, v4, 16, v6
    v_lshl_or_b32 v5, v5, 16, v7
    s_waitcnt lgkmcnt(0)
    v_add_u32 v24, v24, v18
    v_add_u32 v25, v25, v19
    v_mul_u32_u24 v24, 20, v24
    v_mul_u32_u24 v25, 20, v25
    v_add_u32 v24, 2048, v24
    v_add_u32 v25, 2048, v25
    ds_write2_b32 v24, v8, v9 offset0:0 offset1:1
    ds_write2_b32 v24, v12, v13 offset0:2 offset1:3
    ds_write_b32 v24, v4 offset:16
    ds_write2_b32 v25, v10, v11 offset0:0 offset1:1
    ds_write2_b32 v25, v14, v15 offset0:2 offset1:3
    ds_write_b32 v25, v5 offset:16
    s_waitcnt lgkmcnt(0)
    s_barrier
    v_lshlrev_b32 v23, 4, v0
    ds_read_b128 v[4:7], v23 offset:2048
    ds_read_b128 v[8:11], v23 offset:12288
    s_mul_i32 s3, s2, 25600
    v_add_u32 v24, s3, v23
    v_add_u32 v25, 10240, v24
    v_add_u32 v26, 20480, v24
    v_cmp_gt_u32 vcc, 320, v0
    s_waitcnt lgkmcnt(1)
    global_store_dwordx4 v24, v[4:7], s[22:23] sc1
    s_waitcnt lgkmcnt(0)
    global_store_dwordx4 v25, v[8:11], s[22:23] sc1
    s_and_saveexec_b64 s[24:25], vcc
    s_cbranch_execz K1_end2
    ds_read_b128 v[12:15], v23 offset:22528
    s_waitcnt lgkmcnt(0)
    global_store_dwordx4 v26, v[12:15], s[22:23] sc1
K1_end2:
    s_endpgm
K1_wimg:
    s_cmp_ge_u32 s2, 254
    s_cbranch_scc1 K1_done
    v_cmp_gt_u32 vcc, 512, v0
    s_and_saveexec_b64 s[24:25], vcc
    s_cbranch_execz K1_done
    s_sub_u32 s3, s2, 250
    v_bfe_u32 v1, v0, 8, 1
    v_bfe_u32 v2, v0, 6, 2
    v_bfe_u32 v3, v0, 4, 2
    v_bfe_u32 v5, v0, 2, 2
    v_and_b32 v6, 3, v0
    v_lshlrev_b32 v7, 3, v3
    v_lshl_add_u32 v7, v2, 5, v7
    v_lshlrev_b32 v8, 3, v5
    v_lshl_add_u32 v8, v1, 2, v8
    v_add_u32 v8, v8, v6
    s_lshl_b32 s26, s3, 5
    v_add_u32 v8, s26, v8
    v_lshlrev_b32 v8, 1, v8
    v_lshl_add_u32 v8, v7, 8, v8
    s_waitcnt lgkmcnt(0)
    global_load_ushort v16, v8, s[18:19] offset:0
    global_load_ushort v17, v8, s[18:19] offset:256
    global_load_ushort v18, v8, s[18:19] offset:512
    global_load_ushort v19, v8, s[18:19] offset:768
    global_load_ushort v20, v8, s[18:19] offset:1024
    global_load_ushort v21, v8, s[18:19] offset:1280
    global_load_ushort v22, v8, s[18:19] offset:1536
    global_load_ushort v23, v8, s[18:19] offset:1792
    s_lshl_b32 s26, s3, 13
    s_add_u32 s26, s26, 0x780000
    v_lshl_add_u32 v11, v0, 4, s26
    s_waitcnt vmcnt(0)
    v_lshl_or_b32 v12, v17, 16, v16
    v_lshl_or_b32 v13, v19, 16, v18
    v_lshl_or_b32 v14, v21, 16, v20
    v_lshl_or_b32 v15, v23, 16, v22
    global_store_dwordx4 v11, v[12:15], s[22:23] sc1
K1_done:
    s_endpgm
.globl gather_scatter__tensor_product_equiv_mace__graph_kernel
.p2align 8
.type gather_scatter__tensor_product_equiv_mace__graph_kernel,@function
gather_scatter__tensor_product_equiv_mace__graph_kernel:
    s_cmp_ge_u32 s2, 256
    s_cbranch_scc1 K2_done
    s_load_dwordx2 s[22:23], s[0:1], 80
    s_load_dwordx16 s[4:19], s[0:1], 0
    s_load_dwordx2 s[20:21], s[0:1], 64
    v_and_b32 v8, 63, v0
    v_lshrrev_b32 v9, 6, v0
    v_min_u32 v14, 21, v8
    v_readfirstlane_b32 s40, v9
    v_mad_u32_u24 v14, v9, 22, v14
    v_min_u32 v14, 255, v14
    s_and_b32 s3, s2, 7
    s_lshl_b32 s3, s3, 5
    s_lshr_b32 s43, s2, 3
    s_or_b32 s3, s3, s43
    s_lshl_b32 s3, s3, 10
    s_add_u32 s43, s3, 0x700000
    v_lshl_add_u32 v15, v14, 2, s43
    v_and_b32 v16, 31, v14
    v_lshrrev_b32 v14, 5, v14
    v_lshl_add_u32 v14, v16, 3, v14
    v_and_b32 v9, 15, v8
    v_lshrrev_b32 v10, 4, v8
    v_lshlrev_b32 v1, 4, v9
    s_cmp_ge_u32 s40, 12
    s_waitcnt lgkmcnt(0)
    s_cbranch_scc1 K2_hiwaves
    global_load_dword v16, v15, s[22:23]
    s_branch K2_tabs_issued
K2_hiwaves:
    s_mov_b32 s24, s4
    s_and_b32 s25, s5, 0xffff
    s_mov_b32 s26, 10240000
    s_mov_b32 s27, 0x00020000
    s_cmp_eq_u32 s40, 13
    s_cbranch_scc1 K2_cg_issue
    s_cmp_lg_u32 s40, 14
    s_cbranch_scc1 K2_pf
    global_load_dwordx4 v[96:99], v1, s[16:17] offset:0
    global_load_dwordx4 v[100:103], v1, s[16:17] offset:256
    global_load_dwordx4 v[104:107], v1, s[16:17] offset:512
    global_load_dwordx4 v[108:111], v1, s[16:17] offset:768
    s_branch K2_pf
K2_cg_issue:
    v_lshrrev_b32 v11, 2, v9
    v_lshlrev_b32 v18, 3, v10
    v_lshl_add_u32 v18, v11, 1, v18
    global_load_ushort v96, v18, s[14:15] offset:0
    global_load_ushort v97, v18, s[14:15] offset:32
    global_load_ushort v98, v18, s[14:15] offset:64
    global_load_ushort v99, v18, s[14:15] offset:96
K2_pf:
K2_tabs_issued:
    v_lshlrev_b32 v2, 5, v10
    v_lshrrev_b32 v11, 2, v9
    v_and_b32 v12, 3, v9
    v_lshl_add_u32 v13, v11, 2, v10
    v_lshlrev_b32 v13, 5, v13
    v_lshlrev_b32 v13, 4, v10
    v_lshl_add_u32 v3, v11, 2, v13
    v_xor_b32 v13, v9, v10
    v_lshlrev_b32 v13, 4, v13
    v_lshl_add_u32 v4, v10, 8, v13
    v_lshlrev_b32 v5, 3, v8
    v_mov_b32 v23, 1
    s_mov_b32 s32, 0x05040100
    s_mov_b32 s33, 0x07060302
    s_mov_b32 s41, 0
    s_mov_b32 s42, 0
    s_mov_b32 s70, 160
    s_cmp_ge_u32 s40, 12
    s_cselect_b32 s70, 160, s70
    s_lshr_b32 s68, s2, 3
    s_mul_i32 s68, s68, 313
    s_min_u32 s68, s68, 9680
    s_lshl_b32 s68, s68, 10
    s_and_b32 s69, s2, 7
    s_mul_i32 s69, s69, 5
    s_mov_b32 s24, s4
    s_and_b32 s25, s5, 0xffff
    s_mov_b32 s26, 10240000
    s_mov_b32 s27, 0x00020000
    s_mov_b32 s28, s20
    s_and_b32 s29, s21, 0xffff
    s_mov_b32 s30, 10240000
    s_mov_b32 s31, 0x00020000
    v_lshlrev_b32 v18, 4, v0
    v_mov_b32 v24, 0x7f000000
    v_mov_b32 v25, 0x7f000000
    v_mov_b32 v26, 0x7f000000
    v_mov_b32 v27, 0x7f000000
    v_mov_b32 v28, 0
    v_mov_b32 v29, 16
    v_cmp_gt_u32 vcc, 64, v0
    s_and_saveexec_b64 s[44:45], vcc
    v_lshlrev_b32 v19, 2, v0
    ds_write_b32 v19, v28 offset:4096
    ds_write_b32 v19, v28 offset:4608
    ds_write_b32 v19, v28 offset:4864
    v_mov_b32 v19, 0
    ds_write_b64 v19, v[28:29] offset:4864
    s_mov_b64 exec, s[44:45]
    v_cmp_gt_u32 vcc, 960, v0
    s_and_saveexec_b64 s[44:45], vcc
    ds_write_b128 v18, v[24:27] offset:5120
    s_mov_b64 exec, s[44:45]
    v_mov_b32 v24, 0xc000c000
    v_mov_b32 v25, 0xc000c000
    v_mov_b32 v26, 0xc000c000
    v_mov_b32 v27, 0xc000c000
    v_cmp_gt_u32 vcc, 480, v0
    s_and_saveexec_b64 s[44:45], vcc
    ds_write_b128 v18, v[24:27] offset:20480
    s_mov_b64 exec, s[44:45]
    s_mov_b64 s[48:49], 0
    s_mov_b64 s[50:51], 0
    s_mov_b64 s[52:53], 0
    s_mov_b64 s[64:65], 0
    s_waitcnt lgkmcnt(0)
    s_barrier
    s_cmp_lt_u32 s40, 12
    s_cbranch_scc1 K2_lowaves
    v_lshlrev_b32 v18, 4, v0
    v_mov_b32 v28, 0
    v_mov_b32 v29, 0
    v_mov_b32 v30, 0
    v_mov_b32 v31, 0
    v_add_u32 v25, 79616, v18
    v_add_u32 v26, 145152, v18
    v_add_u32 v27, 210688, v18
    ds_write_b128 v25, v[28:31] offset:0
    ds_write_b128 v25, v[28:31] offset:16384
    ds_write_b128 v25, v[28:31] offset:32768
    ds_write_b128 v25, v[28:31] offset:49152
    ds_write_b128 v26, v[28:31] offset:0
    v_cmp_gt_u32 vcc, 16, v0
    s_and_saveexec_b64 s[44:45], vcc
    ds_write_b128 v26, v[28:31] offset:16384
    s_mov_b64 exec, s[44:45]
    s_cmp_eq_u32 s40, 13
    s_cbranch_scc1 K2_cg_build
    s_cmp_lg_u32 s40, 14
    s_cbranch_scc1 K2_hi_wait
    s_waitcnt vmcnt(0)
    v_lshlrev_b32 v112, 16, v96
    v_and_b32 v116, 0xffff0000, v96
    v_lshlrev_b32 v113, 16, v100
    v_and_b32 v117, 0xffff0000, v100
    v_lshlrev_b32 v114, 16, v104
    v_and_b32 v118, 0xffff0000, v104
    v_lshlrev_b32 v115, 16, v108
    v_and_b32 v119, 0xffff0000, v108
    ds_write_b128 v1, v[112:115] offset:0
    ds_write_b128 v1, v[116:119] offset:256
    v_lshlrev_b32 v112, 16, v97
    v_and_b32 v116, 0xffff0000, v97
    v_lshlrev_b32 v113, 16, v101
    v_and_b32 v117, 0xffff0000, v101
    v_lshlrev_b32 v114, 16, v105
    v_and_b32 v118, 0xffff0000, v105
    v_lshlrev_b32 v115, 16, v109
    v_and_b32 v119, 0xffff0000, v109
    ds_write_b128 v1, v[112:115] offset:512
    ds_write_b128 v1, v[116:119] offset:768
    v_lshlrev_b32 v112, 16, v98
    v_and_b32 v116, 0xffff0000, v98
    v_lshlrev_b32 v113, 16, v102
    v_and_b32 v117, 0xffff0000, v102
    v_lshlrev_b32 v114, 16, v106
    v_and_b32 v118, 0xffff0000, v106
    v_lshlrev_b32 v115, 16, v110
    v_and_b32 v119, 0xffff0000, v110
    ds_write_b128 v1, v[112:115] offset:1024
    ds_write_b128 v1, v[116:119] offset:1280
    v_lshlrev_b32 v112, 16, v99
    v_and_b32 v116, 0xffff0000, v99
    v_lshlrev_b32 v113, 16, v103
    v_and_b32 v117, 0xffff0000, v103
    v_lshlrev_b32 v114, 16, v107
    v_and_b32 v118, 0xffff0000, v107
    v_lshlrev_b32 v115, 16, v111
    v_and_b32 v119, 0xffff0000, v111
    ds_write_b128 v1, v[112:115] offset:1536
    ds_write_b128 v1, v[116:119] offset:1792
    s_branch K2_hi_wait
K2_cg_build:
    v_and_b32 v19, 1, v12
    v_lshlrev_b32 v19, 4, v19
    v_cmp_gt_u32 vcc, 2, v12
    s_waitcnt vmcnt(0)
    v_lshlrev_b32 v20, v19, v96
    v_cndmask_b32 v112, 0, v20, vcc
    v_xor_b32 v113, v20, v112
    ds_write_b64 v5, v[112:113] offset:2048
    v_lshlrev_b32 v20, v19, v97
    v_cndmask_b32 v114, 0, v20, vcc
    v_xor_b32 v115, v20, v114
    ds_write_b64 v5, v[114:115] offset:2560
    v_lshlrev_b32 v20, v19, v98
    v_cndmask_b32 v116, 0, v20, vcc
    v_xor_b32 v117, v20, v116
    ds_write_b64 v5, v[116:117] offset:3072
    v_lshlrev_b32 v20, v19, v99
    v_cndmask_b32 v118, 0, v20, vcc
    v_xor_b32 v119, v20, v118
    ds_write_b64 v5, v[118:119] offset:3584
    s_branch K2_hi_wait
K2_lowaves:
    s_mul_i32 s46, s40, 192
    s_add_u32 s46, s46, 28160
    v_add_u32 v20, s46, v8
    v_mov_b32 v28, 0
    ds_write_b8 v20, v28 offset:0
    ds_write_b8 v20, v28 offset:64
    ds_write_b8 v20, v28 offset:128
    v_cmp_gt_u32 vcc, 250, v14
    v_cmp_gt_u32 s[44:45], 22, v8
    s_mul_i32 s3, s40, 22
    v_add_u32 v24, s3, v8
    s_and_b64 vcc, vcc, s[44:45]
    s_nop 0
    s_mov_b32 s47, 25600
    v_mul_lo_u32 v26, v14, s47
    v_add_u32 v27, 1, v8
    s_waitcnt vmcnt(0)
    v_lshrrev_b32 v18, 16, v16
    v_cndmask_b32 v18, 0, v18, vcc
    v_and_b32 v19, 0xffff, v16
    v_mov_b32 v17, v18
    s_nop 1
    v_add_u32_dpp v17, v17, v17 row_shr:1 row_mask:0xf bank_mask:0xf bound_ctrl:0
    s_nop 1
    v_add_u32_dpp v17, v17, v17 row_shr:2 row_mask:0xf bank_mask:0xf bound_ctrl:0
    s_nop 1
    v_add_u32_dpp v17, v17, v17 row_shr:4 row_mask:0xf bank_mask:0xf bound_ctrl:0
    s_nop 1
    v_add_u32_dpp v17, v17, v17 row_shr:8 row_mask:0xf bank_mask:0xf bound_ctrl:0
    s_nop 1
    v_add_u32_dpp v17, v17, v17 row_bcast:15 row_mask:0xa bank_mask:0xf
    s_nop 1
    v_add_u32_dpp v17, v17, v17 row_bcast:31 row_mask:0xc bank_mask:0xf
    s_nop 1
    v_readlane_b32 s36, v17, 63
    v_sub_u32 v17, v17, v18
    v_sub_u32 v19, v19, v17
    v_mad_i32_i24 v26, v19, 20, v26
    v_cmp_lt_u32 vcc, 0, v18
    v_min_u32 v17, 191, v17
    v_add_u32 v17, s46, v17
    s_and_saveexec_b64 s[44:45], vcc
    ds_write_b8 v17, v27
    s_mov_b64 exec, s[44:45]
    ds_read_u8 v28, v20 offset:0
    ds_read_u8 v29, v20 offset:64
    ds_read_u8 v30, v20 offset:128
    s_cmp_gt_u32 s36, 192
    s_cselect_b64 s[64:65], -1, 0
    s_cselect_b32 s36, 0, s36
    s_waitcnt lgkmcnt(0)
    v_max_u32_dpp v28, v28, v28 row_shr:1 row_mask:0xf bank_mask:0xf
    v_max_u32_dpp v29, v29, v29 row_shr:1 row_mask:0xf bank_mask:0xf
    v_max_u32_dpp v30, v30, v30 row_shr:1 row_mask:0xf bank_mask:0xf
    v_max_u32_dpp v28, v28, v28 row_shr:2 row_mask:0xf bank_mask:0xf
    v_max_u32_dpp v29, v29, v29 row_shr:2 row_mask:0xf bank_mask:0xf
    v_max_u32_dpp v30, v30, v30 row_shr:2 row_mask:0xf bank_mask:0xf
    v_max_u32_dpp v28, v28, v28 row_shr:4 row_mask:0xf bank_mask:0xf
    v_max_u32_dpp v29, v29, v29 row_shr:4 row_mask:0xf bank_mask:0xf
    v_max_u32_dpp v30, v30, v30 row_shr:4 row_mask:0xf bank_mask:0xf
    v_max_u32_dpp v28, v28, v28 row_shr:8 row_mask:0xf bank_mask:0xf
    v_max_u32_dpp v29, v29, v29 row_shr:8 row_mask:0xf bank_mask:0xf
    v_max_u32_dpp v30, v30, v30 row_shr:8 row_mask:0xf bank_mask:0xf
    v_max_u32_dpp v28, v28, v28 row_bcast:15 row_mask:0xa bank_mask:0xf
    v_max_u32_dpp v29, v29, v29 row_bcast:15 row_mask:0xa bank_mask:0xf
    v_max_u32_dpp v30, v30, v30 row_bcast:15 row_mask:0xa bank_mask:0xf
    v_max_u32_dpp v28, v28, v28 row_bcast:31 row_mask:0xc bank_mask:0xf
    v_max_u32_dpp v29, v29, v29 row_bcast:31 row_mask:0xc bank_mask:0xf
    v_max_u32_dpp v30, v30, v30 row_bcast:31 row_mask:0xc bank_mask:0xf
    s_nop 0
    v_readlane_b32 s38, v28, 63
    v_readlane_b32 s39, v29, 63
    v_lshlrev_b32 v28, 2, v28
    s_max_u32 s39, s39, s38
    v_max_u32 v29, s38, v29
    v_max_u32 v30, s39, v30
    v_lshlrev_b32 v29, 2, v29
    v_lshlrev_b32 v30, 2, v30
    v_subrev_u32 v28, 4, v28
    ds_bpermute_b32 v28, v28, v26
    v_subrev_u32 v29, 4, v29
    ds_bpermute_b32 v29, v29, v26
    v_subrev_u32 v30, 4, v30
    ds_bpermute_b32 v30, v30, v26
    v_mul_u32_u24 v17, 20, v8
    v_add_u32 v24, 0, v8
    v_cmp_gt_u32 vcc, s36, v24
    s_and_b64 exec, exec, vcc
    s_cbranch_execz K2_loads_done0
    s_mov_b64 s[48:49], exec
    s_waitcnt lgkmcnt(2)
    v_add_u32 v19, v17, v28
    global_load_dwordx4 v[32:35], v19, s[22:23]
    global_load_dword v96, v19, s[22:23] offset:16
    v_add_u32 v17, 1280, v17
    v_add_u32 v24, 64, v8
    v_cmp_gt_u32 vcc, s36, v24
    s_and_b64 exec, exec, vcc
    s_cbranch_execz K2_loads_done0
    s_mov_b64 s[50:51], exec
    s_waitcnt lgkmcnt(1)
    v_add_u32 v19, v17, v29
    global_load_dwordx4 v[40:43], v19, s[22:23]
    global_load_dword v97, v19, s[22:23] offset:16
    v_add_u32 v17, 1280, v17
    v_add_u32 v24, 128, v8
    v_cmp_gt_u32 vcc, s36, v24
    s_and_b64 exec, exec, vcc
    s_cbranch_execz K2_loads_done0
    s_mov_b64 s[52:53], exec
    s_waitcnt lgkmcnt(0)
    v_add_u32 v19, v17, v30
    global_load_dwordx4 v[48:51], v19, s[22:23]
    global_load_dword v98, v19, s[22:23] offset:16
    v_add_u32 v17, 1280, v17
K2_loads_done0:
    s_mov_b64 exec, 1
    ds_add_u32 v1, v23 offset:4876
    s_mov_b64 exec, -1
    s_waitcnt lgkmcnt(0)
    v_lshlrev_b32 v18, 4, v0
    v_mov_b32 v28, 0
    v_mov_b32 v29, 0
    v_mov_b32 v30, 0
    v_mov_b32 v31, 0
    v_add_u32 v25, 79616, v18
    v_add_u32 v26, 145152, v18
    v_add_u32 v27, 210688, v18
    ds_write_b128 v25, v[28:31] offset:0
    ds_write_b128 v25, v[28:31] offset:16384
    ds_write_b128 v25, v[28:31] offset:32768
    ds_write_b128 v25, v[28:31] offset:49152
    ds_write_b128 v26, v[28:31] offset:0
    v_cmp_gt_u32 vcc, 16, v0
    s_and_saveexec_b64 s[44:45], vcc
    ds_write_b128 v26, v[28:31] offset:16384
    s_mov_b64 exec, s[44:45]
    s_branch K2_loads_done
K2_round:
    v_lshlrev_b32 v18, 4, v0
    v_mov_b32 v24, 0x7f000000
    v_mov_b32 v25, 0x7f000000
    v_mov_b32 v26, 0x7f000000
    v_mov_b32 v27, 0x7f000000
    v_mov_b32 v28, 0
    v_mov_b32 v29, 16
    v_cmp_gt_u32 vcc, 64, v0
    s_and_saveexec_b64 s[44:45], vcc
    v_lshlrev_b32 v19, 2, v0
    ds_write_b32 v19, v28 offset:4096
    ds_write_b32 v19, v28 offset:4608
    ds_write_b32 v19, v28 offset:4864
    v_mov_b32 v19, 0
    ds_write_b64 v19, v[28:29] offset:4864
    s_mov_b64 exec, s[44:45]
    v_cmp_gt_u32 vcc, 960, v0
    s_and_saveexec_b64 s[44:45], vcc
    ds_write_b128 v18, v[24:27] offset:5120
    s_mov_b64 exec, s[44:45]
    v_mov_b32 v24, 0xc000c000
    v_mov_b32 v25, 0xc000c000
    v_mov_b32 v26, 0xc000c000
    v_mov_b32 v27, 0xc000c000
    v_cmp_gt_u32 vcc, 480, v0
    s_and_saveexec_b64 s[44:45], vcc
    ds_write_b128 v18, v[24:27] offset:20480
    s_mov_b64 exec, s[44:45]
    s_mov_b64 s[48:49], 0
    s_mov_b64 s[50:51], 0
    s_mov_b64 s[52:53], 0
    s_mov_b64 s[64:65], 0
    s_lshl_b32 s3, s42, 10
    v_add_u32 v14, s3, v0
    v_cmp_gt_u32 vcc, 320000, v14
    v_min_u32 v14, 319999, v14
    v_lshlrev_b32 v15, 2, v14
    v_lshlrev_b32 v16, 3, v14
    global_load_dword v17, v15, s[8:9]
    global_load_dword v18, v15, s[6:7]
    global_load_dwordx2 v[32:33], v16, s[10:11]
    global_load_dwordx2 v[34:35], v16, s[12:13]
    s_waitcnt vmcnt(0) lgkmcnt(0)
    s_barrier
    v_and_b32 v19, 255, v17
    v_cmp_eq_u32 s[46:47], s2, v19
    v_lshrrev_b32 v17, 8, v17
    v_lshl_or_b32 v96, v17, 16, v18
    s_and_b64 s[48:49], vcc, s[46:47]
K2_loads_done:
    s_bcnt1_i32_b64 s36, s[48:49]
    s_bcnt1_i32_b64 s39, s[50:51]
    s_add_u32 s36, s36, s39
    s_bcnt1_i32_b64 s39, s[52:53]
    s_add_u32 s36, s36, s39
    v_mov_b32 v20, s36
    s_mov_b64 exec, 1
    ds_add_rtn_u32 v21, v1, v20 offset:4872
    s_mov_b64 exec, -1
    s_waitcnt lgkmcnt(0)
    v_readfirstlane_b32 s35, v21
    s_add_u32 s36, s36, s35
    s_cmp_le_u32 s36, 1536
    s_cbranch_scc1 K2_sp_ok
    s_mov_b64 s[64:65], -1
    s_mov_b64 s[48:49], 0
K2_sp_ok:
    s_cmp_eq_u64 s[64:65], 0
    s_cbranch_scc1 K2_noflag
    v_mov_b32 v19, 0
    ds_write_b32 v19, v23 offset:4864
K2_noflag:
    s_waitcnt vmcnt(0)
K2_recs_ready:
    s_mov_b64 exec, s[48:49]
    s_cbranch_execz K2_rank_done
    v_lshrrev_b32 v112, 16, v96
    v_lshlrev_b32 v112, 2, v112
    ds_add_rtn_u32 v104, v112, v23 offset:4096
    s_mov_b64 exec, s[50:51]
    s_cbranch_execz K2_rank_done
    v_lshrrev_b32 v113, 16, v97
    v_lshlrev_b32 v113, 2, v113
    ds_add_rtn_u32 v105, v113, v23 offset:4096
    s_mov_b64 exec, s[52:53]
    s_cbranch_execz K2_rank_done
    v_lshrrev_b32 v114, 16, v98
    v_lshlrev_b32 v114, 2, v114
    ds_add_rtn_u32 v106, v114, v23 offset:4096
K2_rank_done:
    s_mov_b64 exec, s[48:49]
    s_cbranch_execz K2_S_done0
    v_lshlrev_b32 v8, 16, v32
    v_and_b32 v9, 0xffff0000, v32
    v_lshlrev_b32 v10, 16, v33
    v_and_b32 v11, 0xffff0000, v33
    v_lshlrev_b32 v12, 16, v34
    v_and_b32 v13, 0xffff0000, v34
    v_lshlrev_b32 v14, 16, v35
    v_and_b32 v15, 0xffff0000, v35
    v_pk_mul_f32 v[28:29], v[12:13], v[8:9] op_sel:[0,0] op_sel_hi:[1,0]
    v_pk_mul_f32 v[30:31], v[14:15], v[8:9] op_sel:[0,0] op_sel_hi:[1,0]
    v_cvt_pk_bf16_f32 v32, v28, v29
    v_cvt_pk_bf16_f32 v33, v30, v31
    v_pk_mul_f32 v[28:29], v[12:13], v[8:9] op_sel:[0,1] op_sel_hi:[1,1]
    v_pk_mul_f32 v[30:31], v[14:15], v[8:9] op_sel:[0,1] op_sel_hi:[1,1]
    v_cvt_pk_bf16_f32 v34, v28, v29
    v_cvt_pk_bf16_f32 v35, v30, v31
    v_pk_mul_f32 v[28:29], v[12:13], v[10:11] op_sel:[0,0] op_sel_hi:[1,0]
    v_pk_mul_f32 v[30:31], v[14:15], v[10:11] op_sel:[0,0] op_sel_hi:[1,0]
    v_cvt_pk_bf16_f32 v36, v28, v29
    v_cvt_pk_bf16_f32 v37, v30, v31
    v_pk_mul_f32 v[28:29], v[12:13], v[10:11] op_sel:[0,1] op_sel_hi:[1,1]
    v_pk_mul_f32 v[30:31], v[14:15], v[10:11] op_sel:[0,1] op_sel_hi:[1,1]
    v_cvt_pk_bf16_f32 v38, v28, v29
    v_cvt_pk_bf16_f32 v39, v30, v31
    v_and_b32 v96, 0xffff, v96
    v_lshlrev_b32 v96, 10, v96
    v_mbcnt_lo_u32_b32 v16, exec_lo, 0
    v_mbcnt_hi_u32_b32 v16, exec_hi, v16
    v_add_lshl_u32 v116, v16, s35, 5
    ds_write_b128 v116, v[32:35] offset:30464
    ds_write_b128 v116, v[36:39] offset:30480
    s_bcnt1_i32_b64 s39, exec
    s_add_u32 s35, s35, s39
    s_mov_b64 exec, s[50:51]
    s_cbranch_execz K2_S_done0
    v_lshlrev_b32 v8, 16, v40
    v_and_b32 v9, 0xffff0000, v40
    v_lshlrev_b32 v10, 16, v41
    v_and_b32 v11, 0xffff0000, v41
    v_lshlrev_b32 v12, 16, v42
    v_and_b32 v13, 0xffff0000, v42
    v_lshlrev_b32 v14, 16, v43
    v_and_b32 v15, 0xffff0000, v43
    v_pk_mul_f32 v[28:29], v[12:13], v[8:9] op_sel:[0,0] op_sel_hi:[1,0]
    v_pk_mul_f32 v[30:31], v[14:15], v[8:9] op_sel:[0,0] op_sel_hi:[1,0]
    v_cvt_pk_bf16_f32 v40, v28, v29
    v_cvt_pk_bf16_f32 v41, v30, v31
    v_pk_mul_f32 v[28:29], v[12:13], v[8:9] op_sel:[0,1] op_sel_hi:[1,1]
    v_pk_mul_f32 v[30:31], v[14:15], v[8:9] op_sel:[0,1] op_sel_hi:[1,1]
    v_cvt_pk_bf16_f32 v42, v28, v29
    v_cvt_pk_bf16_f32 v43, v30, v31
    v_pk_mul_f32 v[28:29], v[12:13], v[10:11] op_sel:[0,0] op_sel_hi:[1,0]
    v_pk_mul_f32 v[30:31], v[14:15], v[10:11] op_sel:[0,0] op_sel_hi:[1,0]
    v_cvt_pk_bf16_f32 v44, v28, v29
    v_cvt_pk_bf16_f32 v45, v30, v31
    v_pk_mul_f32 v[28:29], v[12:13], v[10:11] op_sel:[0,1] op_sel_hi:[1,1]
    v_pk_mul_f32 v[30:31], v[14:15], v[10:11] op_sel:[0,1] op_sel_hi:[1,1]
    v_cvt_pk_bf16_f32 v46, v28, v29
    v_cvt_pk_bf16_f32 v47, v30, v31
    v_and_b32 v97, 0xffff, v97
    v_lshlrev_b32 v97, 10, v97
    v_mbcnt_lo_u32_b32 v16, exec_lo, 0
    v_mbcnt_hi_u32_b32 v16, exec_hi, v16
    v_add_lshl_u32 v117, v16, s35, 5
    ds_write_b128 v117, v[40:43] offset:30464
    ds_write_b128 v117, v[44:47] offset:30480
    s_bcnt1_i32_b64 s39, exec
    s_add_u32 s35, s35, s39
    s_mov_b64 exec, s[52:53]
    s_cbranch_execz K2_S_done0
    v_lshlrev_b32 v8, 16, v48
    v_and_b32 v9, 0xffff0000, v48
    v_lshlrev_b32 v10, 16, v49
    v_and_b32 v11, 0xffff0000, v49
    v_lshlrev_b32 v12, 16, v50
    v_and_b32 v13, 0xffff0000, v50
    v_lshlrev_b32 v14, 16, v51
    v_and_b32 v15, 0xffff0000, v51
    v_pk_mul_f32 v[28:29], v[12:13], v[8:9] op_sel:[0,0] op_sel_hi:[1,0]
    v_pk_mul_f32 v[30:31], v[14:15], v[8:9] op_sel:[0,0] op_sel_hi:[1,0]
    v_cvt_pk_bf16_f32 v48, v28, v29
    v_cvt_pk_bf16_f32 v49, v30, v31
    v_pk_mul_f32 v[28:29], v[12:13], v[8:9] op_sel:[0,1] op_sel_hi:[1,1]
    v_pk_mul_f32 v[30:31], v[14:15], v[8:9] op_sel:[0,1] op_sel_hi:[1,1]
    v_cvt_pk_bf16_f32 v50, v28, v29
    v_cvt_pk_bf16_f32 v51, v30, v31
    v_pk_mul_f32 v[28:29], v[12:13], v[10:11] op_sel:[0,0] op_sel_hi:[1,0]
    v_pk_mul_f32 v[30:31], v[14:15], v[10:11] op_sel:[0,0] op_sel_hi:[1,0]
    v_cvt_pk_bf16_f32 v52, v28, v29
    v_cvt_pk_bf16_f32 v53, v30, v31
    v_pk_mul_f32 v[28:29], v[12:13], v[10:11] op_sel:[0,1] op_sel_hi:[1,1]
    v_pk_mul_f32 v[30:31], v[14:15], v[10:11] op_sel:[0,1] op_sel_hi:[1,1]
    v_cvt_pk_bf16_f32 v54, v28, v29
    v_cvt_pk_bf16_f32 v55, v30, v31
    v_and_b32 v98, 0xffff, v98
    v_lshlrev_b32 v98, 10, v98
    v_mbcnt_lo_u32_b32 v16, exec_lo, 0
    v_mbcnt_hi_u32_b32 v16, exec_hi, v16
    v_add_lshl_u32 v118, v16, s35, 5
    ds_write_b128 v118, v[48:51] offset:30464
    ds_write_b128 v118, v[52:55] offset:30480
    s_bcnt1_i32_b64 s39, exec
    s_add_u32 s35, s35, s39
K2_S_done0:
    s_cmp_lg_u32 s41, 0
    s_cbranch_scc1 K2_S_done
    s_waitcnt lgkmcnt(0)
    s_mov_b64 exec, s[48:49]
    s_cbranch_execz K2_S_done
    v_cmp_gt_u32 vcc, 96, v104
    v_lshrrev_b32 v24, 2, v112
    v_mul_u32_u24 v24, 3, v24
    s_and_b64 exec, exec, vcc
    v_lshrrev_b32 v27, 5, v104
    v_add_lshl_u32 v26, v24, v27, 7
    v_and_b32 v27, 3, v104
    v_lshl_add_u32 v26, v27, 5, v26
    v_lshrrev_b32 v25, 1, v26
    v_and_or_b32 v25, v104, 12, v25
    v_bfe_u32 v27, v104, 4, 1
    v_lshl_or_b32 v25, v27, 1, v25
    ds_write_b16 v25, v116 offset:20480
    v_and_or_b32 v26, v104, 28, v26
    ds_write_b32 v26, v96 offset:5120
    s_mov_b64 exec, s[50:51]
    s_cbranch_execz K2_S_done
    v_cmp_gt_u32 vcc, 96, v105
    v_lshrrev_b32 v24, 2, v113
    v_mul_u32_u24 v24, 3, v24
    s_and_b64 exec, exec, vcc
    v_lshrrev_b32 v27, 5, v105
    v_add_lshl_u32 v26, v24, v27, 7
    v_and_b32 v27, 3, v105
    v_lshl_add_u32 v26, v27, 5, v26
    v_lshrrev_b32 v25, 1, v26
    v_and_or_b32 v25, v105, 12, v25
    v_bfe_u32 v27, v105, 4, 1
    v_lshl_or_b32 v25, v27, 1, v25
    ds_write_b16 v25, v117 offset:20480
    v_and_or_b32 v26, v105, 28, v26
    ds_write_b32 v26, v97 offset:5120
    s_mov_b64 exec, s[52:53]
    s_cbranch_execz K2_S_done
    v_cmp_gt_u32 vcc, 96, v106
    v_lshrrev_b32 v24, 2, v114
    v_mul_u32_u24 v24, 3, v24
    s_and_b64 exec, exec, vcc
    v_lshrrev_b32 v27, 5, v106
    v_add_lshl_u32 v26, v24, v27, 7
    v_and_b32 v27, 3, v106
    v_lshl_add_u32 v26, v27, 5, v26
    v_lshrrev_b32 v25, 1, v26
    v_and_or_b32 v25, v106, 12, v25
    v_bfe_u32 v27, v106, 4, 1
    v_lshl_or_b32 v25, v27, 1, v25
    ds_write_b16 v25, v118 offset:20480
    v_and_or_b32 v26, v106, 28, v26
    ds_write_b32 v26, v98 offset:5120
    s_branch K2_S_done
K2_hi_wait:
    v_mov_b32 v24, 0
    s_mov_b32 s39, 0
K2_hi_wl:
    s_sleep 1
    ds_read_b32 v25, v24 offset:4876
    s_waitcnt lgkmcnt(0)
    v_readfirstlane_b32 s38, v25
    s_add_u32 s39, s39, 1
    s_cmp_ge_u32 s39, 4096
    s_cbranch_scc1 K2_S_done
    s_cmp_ge_u32 s38, 8
    s_cbranch_scc0 K2_hi_wl
    s_lshr_b32 s3, s2, 3
    s_mul_i32 s3, s3, 625
    s_sub_u32 s3, s3, 768
    v_add_u32 v24, s3, v0
    v_lshrrev_b32 v25, 1, v24
    v_and_b32 v24, 1, v24
    v_lshlrev_b32 v24, 7, v24
    v_lshl_add_u32 v24, v25, 10, v24
    buffer_load_dword v120, v24, s[24:27], 0 offen
K2_S_done:
    s_mov_b64 exec, -1
    s_waitcnt lgkmcnt(0)
    s_barrier
    v_lshrrev_b32 v19, 1, v5
    ds_read_b32 v24, v19 offset:4096
    v_mov_b32 v20, 0
    ds_read_b32 v21, v20 offset:4864
    s_waitcnt lgkmcnt(0)
    s_cmp_lg_u32 s41, 0
    s_cbranch_scc1 K2_slow_scan
    v_cmp_lt_u32 vcc, 96, v24
    v_readfirstlane_b32 s35, v21
    v_mul_u32_u24 v20, 3, v19
    v_lshlrev_b32 v20, 9, v20
    v_lshl_or_b32 v6, v24, 18, v20
    s_or_b32 s35, s35, vcc_lo
    s_or_b32 s35, s35, vcc_hi
    s_cmp_eq_u32 s35, 0
    s_cbranch_scc1 K2_main_start
    s_mov_b32 s41, 1
    s_barrier
    s_branch K2_round
K2_slow_scan:
    v_add_u32 v25, 31, v24
    v_lshrrev_b32 v25, 5, v25
    v_lshl_or_b32 v26, v25, 16, v24
    v_mov_b32 v27, v26
    s_nop 1
    v_add_u32_dpp v27, v27, v27 row_shr:1 row_mask:0xf bank_mask:0xf bound_ctrl:0
    s_nop 1
    v_add_u32_dpp v27, v27, v27 row_shr:2 row_mask:0xf bank_mask:0xf bound_ctrl:0
    s_nop 1
    v_add_u32_dpp v27, v27, v27 row_shr:4 row_mask:0xf bank_mask:0xf bound_ctrl:0
    s_nop 1
    v_add_u32_dpp v27, v27, v27 row_shr:8 row_mask:0xf bank_mask:0xf bound_ctrl:0
    s_nop 1
    v_add_u32_dpp v27, v27, v27 row_bcast:15 row_mask:0xa bank_mask:0xf
    s_nop 1
    v_add_u32_dpp v27, v27, v27 row_bcast:31 row_mask:0xc bank_mask:0xf
    s_nop 1
    v_readlane_b32 s34, v27, 63
    v_readfirstlane_b32 s35, v21
    v_sub_u32 v27, v27, v26
    ds_write_b32 v19, v27 offset:4352
    s_and_b32 s36, s34, 0xffff
    s_lshr_b32 s34, s34, 16
    s_cmp_gt_u32 s36, 1536
    s_cselect_b32 s36, 1, 0
    s_or_b32 s35, s35, s36
    s_cmp_eq_u32 s35, 0
    s_cbranch_scc1 K2_ok
    s_mov_b32 s41, 1
    s_waitcnt lgkmcnt(0)
    s_barrier
    s_branch K2_round
K2_ok:
    v_and_b32 v20, 0xffff, v27
    v_lshrrev_b32 v21, 16, v27
    v_lshl_or_b32 v20, v21, 11, v20
    v_lshl_or_b32 v6, v24, 18, v20
    s_mov_b64 exec, s[48:49]
    s_cbranch_execz K2_tabs_done
    ds_read_b32 v112, v112 offset:4352
    s_mov_b64 exec, s[50:51]
    s_cbranch_execz K2_tabs_done
    ds_read_b32 v113, v113 offset:4352
    s_mov_b64 exec, s[52:53]
    s_cbranch_execz K2_tabs_done
    ds_read_b32 v114, v114 offset:4352
K2_tabs_done:
    s_waitcnt lgkmcnt(0)
    s_mov_b64 exec, s[48:49]
    s_cbranch_execz K2_scatter_done
    v_lshrrev_b32 v24, 16, v112
    v_lshrrev_b32 v27, 5, v104
    v_add_lshl_u32 v26, v24, v27, 7
    v_and_b32 v27, 3, v104
    v_lshl_add_u32 v26, v27, 5, v26
    v_lshrrev_b32 v25, 1, v26
    v_and_or_b32 v25, v104, 12, v25
    v_bfe_u32 v27, v104, 4, 1
    v_lshl_or_b32 v25, v27, 1, v25
    ds_write_b16 v25, v116 offset:20480
    v_and_or_b32 v26, v104, 28, v26
    ds_write_b32 v26, v96 offset:5120
    s_mov_b64 exec, s[50:51]
    s_cbranch_execz K2_scatter_done
    v_lshrrev_b32 v24, 16, v113
    v_lshrrev_b32 v27, 5, v105
    v_add_lshl_u32 v26, v24, v27, 7
    v_and_b32 v27, 3, v105
    v_lshl_add_u32 v26, v27, 5, v26
    v_lshrrev_b32 v25, 1, v26
    v_and_or_b32 v25, v105, 12, v25
    v_bfe_u32 v27, v105, 4, 1
    v_lshl_or_b32 v25, v27, 1, v25
    ds_write_b16 v25, v117 offset:20480
    v_and_or_b32 v26, v105, 28, v26
    ds_write_b32 v26, v97 offset:5120
    s_mov_b64 exec, s[52:53]
    s_cbranch_execz K2_scatter_done
    v_lshrrev_b32 v24, 16, v114
    v_lshrrev_b32 v27, 5, v106
    v_add_lshl_u32 v26, v24, v27, 7
    v_and_b32 v27, 3, v106
    v_lshl_add_u32 v26, v27, 5, v26
    v_lshrrev_b32 v25, 1, v26
    v_and_or_b32 v25, v106, 12, v25
    v_bfe_u32 v27, v106, 4, 1
    v_lshl_or_b32 v25, v27, 1, v25
    ds_write_b16 v25, v118 offset:20480
    v_and_or_b32 v26, v106, 28, v26
    ds_write_b32 v26, v98 offset:5120
K2_scatter_done:
    s_mov_b64 exec, -1
    s_waitcnt lgkmcnt(0)
    s_barrier
K2_main_start:
    s_mov_b32 s38, s40
    s_mov_b32 s71, 0
    s_mov_b32 s34, 0xffff
    s_mov_b32 s60, 0
    s_branch G0_dec
G0_retry:
    s_mov_b64 exec, 1
    ds_add_rtn_u32 v7, v1, v23 offset:4868
    s_mov_b64 exec, -1
    s_waitcnt lgkmcnt(0)
    v_readfirstlane_b32 s38, v7
G0_dec:
    s_cmp_lt_u32 s38, 160
    s_cbranch_scc1 G0_valid
    s_mov_b32 s65, 0
    s_mov_b32 s62, 0
    s_branch G0_end
G0_valid:
    s_mul_i32 s60, s38, 1639
    s_lshr_b32 s60, s60, 16
    s_mul_i32 s61, s60, 40
    s_sub_u32 s61, s38, s61
    v_readlane_b32 s39, v6, s61
    s_lshr_b32 s62, s39, 18
    s_cbranch_scc1 G0_ne
    s_andn2_b32 s39, s61, 3
    v_mov_b32 v0, s39
    s_mov_b64 exec, 1
    ds_add_u32 v0, v23 offset:4928
    s_mov_b64 exec, -1
    s_branch G0_retry
G0_ne:
    s_bfe_u32 s63, s39, 0x7000b
    s_and_b32 s64, s39, 0x7ff
    s_lshl_b32 s64, s64, 5
    s_mov_b32 s65, 16
G0_cnt:
    s_min_u32 s39, s62, 32
    s_sub_u32 s62, s62, s39
    s_add_u32 s39, s39, 3
    s_lshr_b32 s39, s39, 2
    s_or_b32 s65, s65, s39
    s_cmp_eq_u32 s62, 0
    s_cselect_b32 s39, 32, 0
    s_or_b32 s65, s65, s39
    s_lshl_b32 s39, s63, 7
    v_add_u32 v0, s39, v2
    ds_read_b128 v[24:27], v0 offset:5120
    ds_read_b128 v[28:31], v0 offset:5136
    s_lshl_b32 s39, s63, 6
    v_add_u32 v0, s39, v3
    ds_read_b32 v22, v0 offset:20480
G0_end:
    s_waitcnt lgkmcnt(0)
    s_lshl_b32 s37, s60, 8
    s_and_b32 s39, s65, 15
    s_cbranch_scc0 L1_e
    v_add_u32 v24, v24, v1
    s_cmp_eq_u32 s39, 1
    buffer_load_dwordx4 v[32:35], v24, s[24:27], s37 offen
    s_cbranch_scc1 L1_e
    v_add_u32 v25, v25, v1
    s_cmp_eq_u32 s39, 2
    buffer_load_dwordx4 v[36:39], v25, s[24:27], s37 offen
    s_cbranch_scc1 L1_e
    v_add_u32 v26, v26, v1
    s_cmp_eq_u32 s39, 3
    buffer_load_dwordx4 v[40:43], v26, s[24:27], s37 offen
    s_cbranch_scc1 L1_e
    v_add_u32 v27, v27, v1
    s_cmp_eq_u32 s39, 4
    buffer_load_dwordx4 v[44:47], v27, s[24:27], s37 offen
    s_cbranch_scc1 L1_e
    v_add_u32 v28, v28, v1
    s_cmp_eq_u32 s39, 5
    buffer_load_dwordx4 v[48:51], v28, s[24:27], s37 offen
    s_cbranch_scc1 L1_e
    v_add_u32 v29, v29, v1
    s_cmp_eq_u32 s39, 6
    buffer_load_dwordx4 v[52:55], v29, s[24:27], s37 offen
    s_cbranch_scc1 L1_e
    v_add_u32 v30, v30, v1
    s_cmp_eq_u32 s39, 7
    buffer_load_dwordx4 v[56:59], v30, s[24:27], s37 offen
    s_cbranch_scc1 L1_e
    v_add_u32 v31, v31, v1
    buffer_load_dwordx4 v[60:63], v31, s[24:27], s37 offen
L1_e:
    s_mov_b64 s[48:49], s[60:61]
    s_mov_b64 s[50:51], s[64:65]
    ds_read_b128 v[64:67], v1 offset:0
    ds_read_b128 v[68:71], v1 offset:256
    ds_read_b128 v[72:75], v1 offset:512
    ds_read_b128 v[76:79], v1 offset:768
    ds_read_b128 v[80:83], v1 offset:1024
    ds_read_b128 v[84:87], v1 offset:1280
    ds_read_b128 v[88:91], v1 offset:1536
    ds_read_b128 v[92:95], v1 offset:1792
K2_loop:
    s_and_b32 s39, s51, 15
    s_cbranch_scc0 K2_main_done
    v_and_b32 v20, 24, v5
    v_and_or_b32 v0, v22, s34, v20
    v_lshrrev_b32 v22, 16, v22
    v_or_b32 v20, v22, v20
    ds_read_b64_tr_b16 v[16:17], v0 offset:30464
    ds_read_b64_tr_b16 v[18:19], v20 offset:30464
    s_cmp_eq_u32 s62, 0
    s_cbranch_scc1 G2_retry
    s_add_u32 s63, s63, 1
    s_add_u32 s64, s64, 1024
    s_mov_b32 s65, 0
    s_branch G2_cnt
G2_retry:
    s_mov_b64 exec, 1
    ds_add_rtn_u32 v7, v1, v23 offset:4868
    s_mov_b64 exec, -1
    s_waitcnt lgkmcnt(0)
    v_readfirstlane_b32 s38, v7
G2_dec:
    s_cmp_lt_u32 s38, 160
    s_cbranch_scc1 G2_valid
    s_mov_b32 s65, 0
    s_mov_b32 s62, 0
    s_branch G2_end
G2_valid:
    s_mul_i32 s60, s38, 1639
    s_lshr_b32 s60, s60, 16
    s_mul_i32 s61, s60, 40
    s_sub_u32 s61, s38, s61
    v_readlane_b32 s39, v6, s61
    s_lshr_b32 s62, s39, 18
    s_cbranch_scc1 G2_ne
    s_andn2_b32 s39, s61, 3
    v_mov_b32 v0, s39
    s_mov_b64 exec, 1
    ds_add_u32 v0, v23 offset:4928
    s_mov_b64 exec, -1
    s_branch G2_retry
G2_ne:
    s_bfe_u32 s63, s39, 0x7000b
    s_and_b32 s64, s39, 0x7ff
    s_lshl_b32 s64, s64, 5
    s_mov_b32 s65, 16
G2_cnt:
    s_min_u32 s39, s62, 32
    s_sub_u32 s62, s62, s39
    s_add_u32 s39, s39, 3
    s_lshr_b32 s39, s39, 2
    s_or_b32 s65, s65, s39
    s_cmp_eq_u32 s62, 0
    s_cselect_b32 s39, 32, 0
    s_or_b32 s65, s65, s39
    s_lshl_b32 s39, s63, 7
    v_add_u32 v0, s39, v2
    ds_read_b128 v[24:27], v0 offset:5120
    ds_read_b128 v[28:31], v0 offset:5136
    s_lshl_b32 s39, s63, 6
    v_add_u32 v0, s39, v3
    ds_read_b32 v22, v0 offset:20480
G2_end:
    s_waitcnt vmcnt(0) lgkmcnt(0)
    s_and_b32 s39, s51, 15
    s_bitcmp0_b32 s51, 4
    s_cbranch_scc1 M0_acc
    s_cmp_gt_u32 s39, 6
    s_cbranch_scc1 M0f4
    s_cmp_gt_u32 s39, 4
    s_cbranch_scc1 M0f3
    s_cmp_gt_u32 s39, 2
    s_cbranch_scc1 M0f2
M0f1:
    s_bitcmp0_b32 s51, 0
    s_cbranch_scc1 Z3
    v_mov_b32 v36, 0
    v_mov_b32 v37, 0
    v_mov_b32 v38, 0
    v_mov_b32 v39, 0
Z3:
    v_mov_b32 v9, 0
    v_mov_b32 v13, 0
    v_perm_b32 v8, v36, v32, s32
    v_perm_b32 v12, v36, v32, s33
    s_nop 0
    v_mfma_f32_16x16x16_bf16 v[96:99], v[16:17], v[8:9], 0
    v_perm_b32 v8, v37, v33, s32
    s_nop 0
    v_mfma_f32_16x16x16_bf16 v[100:103], v[16:17], v[12:13], 0
    v_perm_b32 v12, v37, v33, s33
    s_nop 0
    v_mfma_f32_16x16x16_bf16 v[104:107], v[16:17], v[8:9], 0
    v_perm_b32 v8, v38, v34, s32
    s_nop 0
    v_mfma_f32_16x16x16_bf16 v[108:111], v[16:17], v[12:13], 0
    v_perm_b32 v12, v38, v34, s33
    s_nop 0
    v_mfma_f32_16x16x16_bf16 v[112:115], v[16:17], v[8:9], 0
    v_perm_b32 v8, v39, v35, s32
    s_nop 0
    v_mfma_f32_16x16x16_bf16 v[116:119], v[16:17], v[12:13], 0
    v_perm_b32 v12, v39, v35, s33
    s_nop 0
    v_mfma_f32_16x16x16_bf16 v[120:123], v[16:17], v[8:9], 0
    s_nop 0
    v_mfma_f32_16x16x16_bf16 v[124:127], v[16:17], v[12:13], 0
    s_branch M0_done
M0f2:
    s_bitcmp0_b32 s51, 0
    s_cbranch_scc1 Z4
    v_mov_b32 v44, 0
    v_mov_b32 v45, 0
    v_mov_b32 v46, 0
    v_mov_b32 v47, 0
Z4:
    v_perm_b32 v8, v36, v32, s32
    v_perm_b32 v9, v44, v40, s32
    v_perm_b32 v12, v36, v32, s33
    v_perm_b32 v13, v44, v40, s33
    v_mfma_f32_16x16x16_bf16 v[96:99], v[16:17], v[8:9], 0
    v_perm_b32 v8, v37, v33, s32
    v_perm_b32 v9, v45, v41, s32
    v_mfma_f32_16x16x16_bf16 v[100:103], v[16:17], v[12:13], 0
    v_perm_b32 v12, v37, v33, s33
    v_perm_b32 v13, v45, v41, s33
    v_mfma_f32_16x16x16_bf16 v[104:107], v[16:17], v[8:9], 0
    v_perm_b32 v8, v38, v34, s32
    v_perm_b32 v9, v46, v42, s32
    v_mfma_f32_16x16x16_bf16 v[108:111], v[16:17], v[12:13], 0
    v_perm_b32 v12, v38, v34, s33
    v_perm_b32 v13, v46, v42, s33
    v_mfma_f32_16x16x16_bf16 v[112:115], v[16:17], v[8:9], 0
    v_perm_b32 v8, v39, v35, s32
    v_perm_b32 v9, v47, v43, s32
    v_mfma_f32_16x16x16_bf16 v[116:119], v[16:17], v[12:13], 0
    v_perm_b32 v12, v39, v35, s33
    v_perm_b32 v13, v47, v43, s33
    v_mfma_f32_16x16x16_bf16 v[120:123], v[16:17], v[8:9], 0
    s_nop 0
    v_mfma_f32_16x16x16_bf16 v[124:127], v[16:17], v[12:13], 0
    s_branch M0_done
M0f3:
    s_bitcmp0_b32 s51, 0
    s_cbranch_scc1 Z5
    v_mov_b32 v52, 0
    v_mov_b32 v53, 0
    v_mov_b32 v54, 0
    v_mov_b32 v55, 0
Z5:
    v_mov_b32 v11, 0
    v_mov_b32 v15, 0
    v_perm_b32 v8, v36, v32, s32
    v_perm_b32 v9, v44, v40, s32
    v_perm_b32 v10, v52, v48, s32
    v_perm_b32 v12, v36, v32, s33
    v_perm_b32 v13, v44, v40, s33
    v_perm_b32 v14, v52, v48, s33
    v_mfma_f32_16x16x32_bf16 v[96:99], v[16:19], v[8:11], 0
    v_perm_b32 v8, v37, v33, s32
    v_perm_b32 v9, v45, v41, s32
    v_perm_b32 v10, v53, v49, s32
    v_mfma_f32_16x16x32_bf16 v[100:103], v[16:19], v[12:15], 0
    v_perm_b32 v12, v37, v33, s33
    v_perm_b32 v13, v45, v41, s33
    v_perm_b32 v14, v53, v49, s33
    v_mfma_f32_16x16x32_bf16 v[104:107], v[16:19], v[8:11], 0
    v_perm_b32 v8, v38, v34, s32
    v_perm_b32 v9, v46, v42, s32
    v_perm_b32 v10, v54, v50, s32
    v_mfma_f32_16x16x32_bf16 v[108:111], v[16:19], v[12:15], 0
    v_perm_b32 v12, v38, v34, s33
    v_perm_b32 v13, v46, v42, s33
    v_perm_b32 v14, v54, v50, s33
    v_mfma_f32_16x16x32_bf16 v[112:115], v[16:19], v[8:11], 0
    v_perm_b32 v8, v39, v35, s32
    v_perm_b32 v9, v47, v43, s32
    v_perm_b32 v10, v55, v51, s32
    v_mfma_f32_16x16x32_bf16 v[116:119], v[16:19], v[12:15], 0
    v_perm_b32 v12, v39, v35, s33
    v_perm_b32 v13, v47, v43, s33
    v_perm_b32 v14, v55, v51, s33
    v_mfma_f32_16x16x32_bf16 v[120:123], v[16:19], v[8:11], 0
    s_nop 0
    v_mfma_f32_16x16x32_bf16 v[124:127], v[16:19], v[12:15], 0
    s_branch M0_done
M0f4:
    s_bitcmp0_b32 s51, 0
    s_cbranch_scc1 Z6
    v_mov_b32 v60, 0
    v_mov_b32 v61, 0
    v_mov_b32 v62, 0
    v_mov_b32 v63, 0
Z6:
    v_perm_b32 v8, v36, v32, s32
    v_perm_b32 v9, v44, v40, s32
    v_perm_b32 v10, v52, v48, s32
    v_perm_b32 v11, v60, v56, s32
    v_perm_b32 v12, v36, v32, s33
    v_perm_b32 v13, v44, v40, s33
    v_perm_b32 v14, v52, v48, s33
    v_perm_b32 v15, v60, v56, s33
    v_mfma_f32_16x16x32_bf16 v[96:99], v[16:19], v[8:11], 0
    v_perm_b32 v8, v37, v33, s32
    v_perm_b32 v9, v45, v41, s32
    v_perm_b32 v10, v53, v49, s32
    v_perm_b32 v11, v61, v57, s32
    v_mfma_f32_16x16x32_bf16 v[100:103], v[16:19], v[12:15], 0
    v_perm_b32 v12, v37, v33, s33
    v_perm_b32 v13, v45, v41, s33
    v_perm_b32 v14, v53, v49, s33
    v_perm_b32 v15, v61, v57, s33
    v_mfma_f32_16x16x32_bf16 v[104:107], v[16:19], v[8:11], 0
    v_perm_b32 v8, v38, v34, s32
    v_perm_b32 v9, v46, v42, s32
    v_perm_b32 v10, v54, v50, s32
    v_perm_b32 v11, v62, v58, s32
    v_mfma_f32_16x16x32_bf16 v[108:111], v[16:19], v[12:15], 0
    v_perm_b32 v12, v38, v34, s33
    v_perm_b32 v13, v46, v42, s33
    v_perm_b32 v14, v54, v50, s33
    v_perm_b32 v15, v62, v58, s33
    v_mfma_f32_16x16x32_bf16 v[112:115], v[16:19], v[8:11], 0
    v_perm_b32 v8, v39, v35, s32
    v_perm_b32 v9, v47, v43, s32
    v_perm_b32 v10, v55, v51, s32
    v_perm_b32 v11, v63, v59, s32
    v_mfma_f32_16x16x32_bf16 v[116:119], v[16:19], v[12:15], 0
    v_perm_b32 v12, v39, v35, s33
    v_perm_b32 v13, v47, v43, s33
    v_perm_b32 v14, v55, v51, s33
    v_perm_b32 v15, v63, v59, s33
    v_mfma_f32_16x16x32_bf16 v[120:123], v[16:19], v[8:11], 0
    s_nop 0
    v_mfma_f32_16x16x32_bf16 v[124:127], v[16:19], v[12:15], 0
    s_branch M0_done
M0_acc:
    s_cmp_gt_u32 s39, 6
    s_cbranch_scc1 M0a4
    s_cmp_gt_u32 s39, 4
    s_cbranch_scc1 M0a3
    s_cmp_gt_u32 s39, 2
    s_cbranch_scc1 M0a2
M0a1:
    s_bitcmp0_b32 s51, 0
    s_cbranch_scc1 Z7
    v_mov_b32 v36, 0
    v_mov_b32 v37, 0
    v_mov_b32 v38, 0
    v_mov_b32 v39, 0
Z7:
    v_mov_b32 v9, 0
    v_mov_b32 v13, 0
    v_perm_b32 v8, v36, v32, s32
    v_perm_b32 v12, v36, v32, s33
    s_nop 0
    v_mfma_f32_16x16x16_bf16 v[96:99], v[16:17], v[8:9], v[96:99]
    v_perm_b32 v8, v37, v33, s32
    s_nop 0
    v_mfma_f32_16x16x16_bf16 v[100:103], v[16:17], v[12:13], v[100:103]
    v_perm_b32 v12, v37, v33, s33
    s_nop 0
    v_mfma_f32_16x16x16_bf16 v[104:107], v[16:17], v[8:9], v[104:107]
    v_perm_b32 v8, v38, v34, s32
    s_nop 0
    v_mfma_f32_16x16x16_bf16 v[108:111], v[16:17], v[12:13], v[108:111]
    v_perm_b32 v12, v38, v34, s33
    s_nop 0
    v_mfma_f32_16x16x16_bf16 v[112:115], v[16:17], v[8:9], v[112:115]
    v_perm_b32 v8, v39, v35, s32
    s_nop 0
    v_mfma_f32_16x16x16_bf16 v[116:119], v[16:17], v[12:13], v[116:119]
    v_perm_b32 v12, v39, v35, s33
    s_nop 0
    v_mfma_f32_16x16x16_bf16 v[120:123], v[16:17], v[8:9], v[120:123]
    s_nop 0
    v_mfma_f32_16x16x16_bf16 v[124:127], v[16:17], v[12:13], v[124:127]
    s_branch M0_done
M0a2:
    s_bitcmp0_b32 s51, 0
    s_cbranch_scc1 Z8
    v_mov_b32 v44, 0
    v_mov_b32 v45, 0
    v_mov_b32 v46, 0
    v_mov_b32 v47, 0
Z8:
    v_perm_b32 v8, v36, v32, s32
    v_perm_b32 v9, v44, v40, s32
    v_perm_b32 v12, v36, v32, s33
    v_perm_b32 v13, v44, v40, s33
    v_mfma_f32_16x16x16_bf16 v[96:99], v[16:17], v[8:9], v[96:99]
    v_perm_b32 v8, v37, v33, s32
    v_perm_b32 v9, v45, v41, s32
    v_mfma_f32_16x16x16_bf16 v[100:103], v[16:17], v[12:13], v[100:103]
    v_perm_b32 v12, v37, v33, s33
    v_perm_b32 v13, v45, v41, s33
    v_mfma_f32_16x16x16_bf16 v[104:107], v[16:17], v[8:9], v[104:107]
    v_perm_b32 v8, v38, v34, s32
    v_perm_b32 v9, v46, v42, s32
    v_mfma_f32_16x16x16_bf16 v[108:111], v[16:17], v[12:13], v[108:111]
    v_perm_b32 v12, v38, v34, s33
    v_perm_b32 v13, v46, v42, s33
    v_mfma_f32_16x16x16_bf16 v[112:115], v[16:17], v[8:9], v[112:115]
    v_perm_b32 v8, v39, v35, s32
    v_perm_b32 v9, v47, v43, s32
    v_mfma_f32_16x16x16_bf16 v[116:119], v[16:17], v[12:13], v[116:119]
    v_perm_b32 v12, v39, v35, s33
    v_perm_b32 v13, v47, v43, s33
    v_mfma_f32_16x16x16_bf16 v[120:123], v[16:17], v[8:9], v[120:123]
    s_nop 0
    v_mfma_f32_16x16x16_bf16 v[124:127], v[16:17], v[12:13], v[124:127]
    s_branch M0_done
M0a3:
    s_bitcmp0_b32 s51, 0
    s_cbranch_scc1 Z9
    v_mov_b32 v52, 0
    v_mov_b32 v53, 0
    v_mov_b32 v54, 0
    v_mov_b32 v55, 0
Z9:
    v_mov_b32 v11, 0
    v_mov_b32 v15, 0
    v_perm_b32 v8, v36, v32, s32
    v_perm_b32 v9, v44, v40, s32
    v_perm_b32 v10, v52, v48, s32
    v_perm_b32 v12, v36, v32, s33
    v_perm_b32 v13, v44, v40, s33
    v_perm_b32 v14, v52, v48, s33
    v_mfma_f32_16x16x32_bf16 v[96:99], v[16:19], v[8:11], v[96:99]
    v_perm_b32 v8, v37, v33, s32
    v_perm_b32 v9, v45, v41, s32
    v_perm_b32 v10, v53, v49, s32
    v_mfma_f32_16x16x32_bf16 v[100:103], v[16:19], v[12:15], v[100:103]
    v_perm_b32 v12, v37, v33, s33
    v_perm_b32 v13, v45, v41, s33
    v_perm_b32 v14, v53, v49, s33
    v_mfma_f32_16x16x32_bf16 v[104:107], v[16:19], v[8:11], v[104:107]
    v_perm_b32 v8, v38, v34, s32
    v_perm_b32 v9, v46, v42, s32
    v_perm_b32 v10, v54, v50, s32
    v_mfma_f32_16x16x32_bf16 v[108:111], v[16:19], v[12:15], v[108:111]
    v_perm_b32 v12, v38, v34, s33
    v_perm_b32 v13, v46, v42, s33
    v_perm_b32 v14, v54, v50, s33
    v_mfma_f32_16x16x32_bf16 v[112:115], v[16:19], v[8:11], v[112:115]
    v_perm_b32 v8, v39, v35, s32
    v_perm_b32 v9, v47, v43, s32
    v_perm_b32 v10, v55, v51, s32
    v_mfma_f32_16x16x32_bf16 v[116:119], v[16:19], v[12:15], v[116:119]
    v_perm_b32 v12, v39, v35, s33
    v_perm_b32 v13, v47, v43, s33
    v_perm_b32 v14, v55, v51, s33
    v_mfma_f32_16x16x32_bf16 v[120:123], v[16:19], v[8:11], v[120:123]
    s_nop 0
    v_mfma_f32_16x16x32_bf16 v[124:127], v[16:19], v[12:15], v[124:127]
    s_branch M0_done
M0a4:
    s_bitcmp0_b32 s51, 0
    s_cbranch_scc1 Z10
    v_mov_b32 v60, 0
    v_mov_b32 v61, 0
    v_mov_b32 v62, 0
    v_mov_b32 v63, 0
Z10:
    v_perm_b32 v8, v36, v32, s32
    v_perm_b32 v9, v44, v40, s32
    v_perm_b32 v10, v52, v48, s32
    v_perm_b32 v11, v60, v56, s32
    v_perm_b32 v12, v36, v32, s33
    v_perm_b32 v13, v44, v40, s33
    v_perm_b32 v14, v52, v48, s33
    v_perm_b32 v15, v60, v56, s33
    v_mfma_f32_16x16x32_bf16 v[96:99], v[16:19], v[8:11], v[96:99]
    v_perm_b32 v8, v37, v33, s32
    v_perm_b32 v9, v45, v41, s32
    v_perm_b32 v10, v53, v49, s32
    v_perm_b32 v11, v61, v57, s32
    v_mfma_f32_16x16x32_bf16 v[100:103], v[16:19], v[12:15], v[100:103]
    v_perm_b32 v12, v37, v33, s33
    v_perm_b32 v13, v45, v41, s33
    v_perm_b32 v14, v53, v49, s33
    v_perm_b32 v15, v61, v57, s33
    v_mfma_f32_16x16x32_bf16 v[104:107], v[16:19], v[8:11], v[104:107]
    v_perm_b32 v8, v38, v34, s32
    v_perm_b32 v9, v46, v42, s32
    v_perm_b32 v10, v54, v50, s32
    v_perm_b32 v11, v62, v58, s32
    v_mfma_f32_16x16x32_bf16 v[108:111], v[16:19], v[12:15], v[108:111]
    v_perm_b32 v12, v38, v34, s33
    v_perm_b32 v13, v46, v42, s33
    v_perm_b32 v14, v54, v50, s33
    v_perm_b32 v15, v62, v58, s33
    v_mfma_f32_16x16x32_bf16 v[112:115], v[16:19], v[8:11], v[112:115]
    v_perm_b32 v8, v39, v35, s32
    v_perm_b32 v9, v47, v43, s32
    v_perm_b32 v10, v55, v51, s32
    v_perm_b32 v11, v63, v59, s32
    v_mfma_f32_16x16x32_bf16 v[116:119], v[16:19], v[12:15], v[116:119]
    v_perm_b32 v12, v39, v35, s33
    v_perm_b32 v13, v47, v43, s33
    v_perm_b32 v14, v55, v51, s33
    v_perm_b32 v15, v63, v59, s33
    v_mfma_f32_16x16x32_bf16 v[120:123], v[16:19], v[8:11], v[120:123]
    s_nop 0
    v_mfma_f32_16x16x32_bf16 v[124:127], v[16:19], v[12:15], v[124:127]
M0_done:
    s_lshl_b32 s37, s60, 8
    s_and_b32 s39, s65, 15
    s_cbranch_scc0 L11_e
    v_add_u32 v24, v24, v1
    s_cmp_eq_u32 s39, 1
    buffer_load_dwordx4 v[32:35], v24, s[24:27], s37 offen
    s_cbranch_scc1 L11_e
    v_add_u32 v25, v25, v1
    s_cmp_eq_u32 s39, 2
    buffer_load_dwordx4 v[36:39], v25, s[24:27], s37 offen
    s_cbranch_scc1 L11_e
    v_add_u32 v26, v26, v1
    s_cmp_eq_u32 s39, 3
    buffer_load_dwordx4 v[40:43], v26, s[24:27], s37 offen
    s_cbranch_scc1 L11_e
    v_add_u32 v27, v27, v1
    s_cmp_eq_u32 s39, 4
    buffer_load_dwordx4 v[44:47], v27, s[24:27], s37 offen
    s_cbranch_scc1 L11_e
    v_add_u32 v28, v28, v1
    s_cmp_eq_u32 s39, 5
    buffer_load_dwordx4 v[48:51], v28, s[24:27], s37 offen
    s_cbranch_scc1 L11_e
    v_add_u32 v29, v29, v1
    s_cmp_eq_u32 s39, 6
    buffer_load_dwordx4 v[52:55], v29, s[24:27], s37 offen
    s_cbranch_scc1 L11_e
    v_add_u32 v30, v30, v1
    s_cmp_eq_u32 s39, 7
    buffer_load_dwordx4 v[56:59], v30, s[24:27], s37 offen
    s_cbranch_scc1 L11_e
    v_add_u32 v31, v31, v1
    buffer_load_dwordx4 v[60:63], v31, s[24:27], s37 offen
L11_e:
    s_bitcmp0_b32 s51, 5
    s_cbranch_scc1 K2_cont0
    s_lshl_b32 s38, s48, 9
    v_add_u32 v0, s38, v5
    ds_read_b64 v[20:21], v0 offset:2048
    s_lshl_b32 s38, s49, 2
    v_mov_b32 v16, s38
    s_and_b32 s38, s49, 3
    s_lshl_b32 s38, s38, 6
    s_lshl_b32 s39, s49, 11
    s_add_u32 s39, s39, 79872
    s_or_b32 s38, s38, s39
    v_xor_b32 v17, s38, v4
    v_mov_b32 v19, 0
    v_mul_f32 v96, v96, v64
    v_fmac_f32 v96, v97, v65
    v_fmac_f32 v96, v98, v66
    v_fmac_f32 v96, v99, v67
    v_mul_f32 v100, v100, v68
    v_fmac_f32 v100, v101, v69
    v_fmac_f32 v100, v102, v70
    v_fmac_f32 v100, v103, v71
    v_mul_f32 v104, v104, v72
    v_fmac_f32 v104, v105, v73
    v_fmac_f32 v104, v106, v74
    v_fmac_f32 v104, v107, v75
    v_mul_f32 v108, v108, v76
    v_fmac_f32 v108, v109, v77
    v_fmac_f32 v108, v110, v78
    v_fmac_f32 v108, v111, v79
    v_cvt_pk_bf16_f32 v98, v96, v100
    v_cvt_pk_bf16_f32 v99, v104, v108
    s_mov_b64 exec, 1
    ds_wrxchg_rtn_b32 v18, v16, v23 offset:4608
    s_mov_b64 exec, -1
    ds_read_b128 v[8:11], v17
    ds_read_b128 v[12:15], v17 offset:1024
    v_mul_f32 v112, v112, v80
    v_fmac_f32 v112, v113, v81
    v_fmac_f32 v112, v114, v82
    v_fmac_f32 v112, v115, v83
    v_mul_f32 v116, v116, v84
    v_fmac_f32 v116, v117, v85
    v_fmac_f32 v116, v118, v86
    v_fmac_f32 v116, v119, v87
    v_mul_f32 v120, v120, v88
    v_fmac_f32 v120, v121, v89
    v_fmac_f32 v120, v122, v90
    v_fmac_f32 v120, v123, v91
    v_mul_f32 v124, v124, v92
    v_fmac_f32 v124, v125, v93
    v_fmac_f32 v124, v126, v94
    v_fmac_f32 v124, v127, v95
    v_cvt_pk_bf16_f32 v102, v112, v116
    v_cvt_pk_bf16_f32 v103, v120, v124
P0_chk:
    s_waitcnt lgkmcnt(0)
    v_readfirstlane_b32 s38, v18
    s_cmp_eq_u32 s38, 0
    s_cbranch_scc1 P0_got
    s_mov_b64 exec, 1
    ds_wrxchg_rtn_b32 v18, v16, v23 offset:4608
    s_mov_b64 exec, -1
    ds_read_b128 v[8:11], v17
    ds_read_b128 v[12:15], v17 offset:1024
    s_branch P0_chk
P0_got:
    v_mfma_f32_16x16x16_bf16 v[8:11], v[20:21], v[98:99], v[8:11]
    v_mfma_f32_16x16x16_bf16 v[12:15], v[20:21], v[102:103], v[12:15]
    s_nop 7
    ds_write_b128 v17, v[8:11]
    ds_write_b128 v17, v[12:15] offset:1024
    s_mov_b64 exec, 1
    ds_write_b32 v16, v19 offset:4608
    s_andn2_b32 s38, s49, 3
    v_mov_b32 v18, s38
    ds_add_u32 v18, v23 offset:4928
    s_mov_b64 exec, -1
K2_cont0:
    s_mov_b64 s[48:49], s[60:61]
    s_mov_b64 s[50:51], s[64:65]
    s_branch K2_loop
K2_main_done:
    s_cmp_eq_u32 s41, 0
    s_cbranch_scc1 K2_final
    s_add_u32 s42, s42, 1
    s_cmp_ge_u32 s42, 313
    s_cbranch_scc1 K2_final
    s_waitcnt vmcnt(0) lgkmcnt(0)
    s_barrier
    s_lshl_b32 s39, s40, 6
    v_lshrrev_b32 v0, 3, v5
    v_add_u32 v0, s39, v0
    s_branch K2_round
K2_final:
    s_and_b32 s44, s40, 3
    s_lshr_b32 s45, s40, 2
    s_lshl_b32 s39, s44, 13
    s_add_u32 s39, s39, 0x780000
    v_lshlrev_b32 v8, 1, v5
    v_add_u32 v8, s39, v8
    v_add_u32 v9, 0x1000, v8
    s_waitcnt vmcnt(0)
    global_load_dwordx4 v[32:35], v8, s[22:23] offset:0
    global_load_dwordx4 v[36:39], v8, s[22:23] offset:1024
    global_load_dwordx4 v[40:43], v8, s[22:23] offset:2048
    global_load_dwordx4 v[44:47], v8, s[22:23] offset:3072
    global_load_dwordx4 v[48:51], v9, s[22:23] offset:0
    global_load_dwordx4 v[52:55], v9, s[22:23] offset:1024
    global_load_dwordx4 v[56:59], v9, s[22:23] offset:2048
    global_load_dwordx4 v[60:63], v9, s[22:23] offset:3072
    v_lshrrev_b32 v10, 3, v5
    v_bfe_u32 v11, v10, 2, 2
    v_and_b32 v12, 3, v10
    v_lshrrev_b32 v17, 4, v10
    v_and_b32 v13, 15, v10
    v_xor_b32 v13, v13, v17
    v_lshlrev_b32 v15, 11, v11
    v_lshl_add_u32 v15, v12, 8, v15
    v_lshl_add_u32 v15, v13, 4, v15
    v_lshlrev_b32 v16, 18, v11
    v_lshl_add_u32 v16, v12, 8, v16
    v_lshl_add_u32 v16, v17, 4, v16
    s_lshl_b32 s39, s2, 10
    s_lshl_b32 s46, s44, 6
    s_add_u32 s39, s39, s46
    v_add_u32 v16, s39, v16
    s_lshl_b32 s39, s44, 2
    v_mov_b32 v8, s39
    v_mov_b32 v14, 1
    s_mov_b64 exec, 1
    ds_add_rtn_u32 v9, v8, v14 offset:4880
    s_mov_b64 exec, -1
    s_waitcnt vmcnt(0)
K2_fin_loop:
    s_waitcnt lgkmcnt(0)
    v_readfirstlane_b32 s45, v9
    s_cmp_ge_u32 s45, 10
    s_cbranch_scc1 K2_fin_end
    s_lshl_b32 s39, s45, 2
    v_mov_b32 v10, s39
K2_fin_wait:
    ds_read_b32 v11, v10 offset:4928
    s_waitcnt lgkmcnt(0)
    v_readfirstlane_b32 s39, v11
    s_cmp_ge_u32 s39, 16
    s_cbranch_scc1 K2_fin_go
    s_sleep 2
    s_branch K2_fin_wait
K2_fin_go:
    s_lshl_b32 s39, s45, 13
    s_add_u32 s39, s39, 79872
    v_add_u32 v18, s39, v15
    ds_read_b128 v[64:67], v18
    ds_read_b128 v[68:71], v18 offset:1024
    v_xor_b32 v19, 64, v18
    ds_read_b128 v[72:75], v19
    ds_read_b128 v[76:79], v19 offset:1024
    v_xor_b32 v19, 128, v18
    ds_read_b128 v[80:83], v19
    ds_read_b128 v[84:87], v19 offset:1024
    v_xor_b32 v19, 192, v18
    ds_read_b128 v[88:91], v19
    ds_read_b128 v[92:95], v19 offset:1024
    s_mov_b64 exec, 1
    ds_add_rtn_u32 v9, v8, v14 offset:4880
    s_mov_b64 exec, -1
    s_waitcnt lgkmcnt(7)
    v_cvt_pk_bf16_f32 v96, v64, v65
    v_cvt_pk_bf16_f32 v97, v66, v67
    v_cvt_pk_bf16_f32 v98, v68, v69
    v_cvt_pk_bf16_f32 v99, v70, v71
    s_waitcnt lgkmcnt(5)
    v_cvt_pk_bf16_f32 v100, v72, v73
    v_cvt_pk_bf16_f32 v101, v74, v75
    v_cvt_pk_bf16_f32 v102, v76, v77
    v_cvt_pk_bf16_f32 v103, v78, v79
    s_waitcnt lgkmcnt(3)
    v_cvt_pk_bf16_f32 v104, v80, v81
    v_cvt_pk_bf16_f32 v105, v82, v83
    v_cvt_pk_bf16_f32 v106, v84, v85
    v_cvt_pk_bf16_f32 v107, v86, v87
    s_waitcnt lgkmcnt(1)
    v_cvt_pk_bf16_f32 v108, v88, v89
    v_cvt_pk_bf16_f32 v109, v90, v91
    v_cvt_pk_bf16_f32 v110, v92, v93
    v_cvt_pk_bf16_f32 v111, v94, v95
    s_nop 1
    v_mfma_f32_16x16x32_bf16 v[20:23], v[32:35], v[96:99], 0
    v_mfma_f32_16x16x32_bf16 v[24:27], v[48:51], v[96:99], 0
    v_mfma_f32_16x16x32_bf16 v[20:23], v[36:39], v[100:103], v[20:23]
    v_mfma_f32_16x16x32_bf16 v[24:27], v[52:55], v[100:103], v[24:27]
    v_mfma_f32_16x16x32_bf16 v[20:23], v[40:43], v[104:107], v[20:23]
    v_mfma_f32_16x16x32_bf16 v[24:27], v[56:59], v[104:107], v[24:27]
    v_mfma_f32_16x16x32_bf16 v[20:23], v[44:47], v[108:111], v[20:23]
    v_mfma_f32_16x16x32_bf16 v[24:27], v[60:63], v[108:111], v[24:27]
    s_lshl_b32 s39, s45, 20
    s_nop 7
    v_cvt_pk_bf16_f32 v28, v20, v21
    v_cvt_pk_bf16_f32 v29, v22, v23
    v_cvt_pk_bf16_f32 v30, v24, v25
    v_cvt_pk_bf16_f32 v31, v26, v27
    buffer_store_dwordx4 v[28:31], v16, s[28:31], s39 offen sc1
    s_branch K2_fin_loop
K2_fin_end:
K2_done:
    s_endpgm
.section .rodata,"a"
.p2align 6
.amdhsa_kernel gs_bin_kernel
  .amdhsa_next_free_vgpr 48
  .amdhsa_next_free_sgpr 32
  .amdhsa_accum_offset 48
  .amdhsa_group_segment_fixed_size 0
  .amdhsa_kernarg_size 88
  .amdhsa_user_sgpr_count 2
  .amdhsa_user_sgpr_kernarg_segment_ptr 1
  .amdhsa_system_sgpr_workgroup_id_x 1
  .amdhsa_float_denorm_mode_32 3
.end_amdhsa_kernel
.p2align 6
.amdhsa_kernel gather_scatter__tensor_product_equiv_mace__graph_kernel
  .amdhsa_next_free_vgpr 128
  .amdhsa_next_free_sgpr 72
  .amdhsa_accum_offset 128
  .amdhsa_group_segment_fixed_size 0
  .amdhsa_kernarg_size 88
  .amdhsa_user_sgpr_count 2
  .amdhsa_user_sgpr_kernarg_segment_ptr 1
  .amdhsa_system_sgpr_workgroup_id_x 1
  .amdhsa_float_denorm_mode_32 3
.end_amdhsa_kernel
```
